```python
import torch

def _softmax(x, axis=-1):
    return torch.softmax(x, dim=axis)
def _gelu(x):
    return torch.nn.functional.gelu(x, approximate="tanh")
def _silu(x):
    return torch.nn.functional.silu(x)
def _sigmoid(x):
    return torch.sigmoid(x)
def _layernorm(x, axis=-1, eps=1e-5):
    m = x.mean(dim=axis, keepdim=True)
    v = x.var(dim=axis, keepdim=True, unbiased=False)
    return (x - m) / torch.sqrt(v + eps)
def _scatter_add(tgt, idx, src, axis=0):
    return tgt.clone().index_add_(axis, idx, src)
def _segment_sum(src, seg, n):
    out = torch.zeros((n,) + src.shape[1:], dtype=src.dtype)
    return out.index_add_(0, seg, src)
def _pad(x, pw):
    flat = tuple(v for pair in reversed(pw) for v in pair)
    return torch.nn.functional.pad(x, flat)

kernel_name = 'standalone__rmsnorm__sampling'

def setup_inputs():

    _w = (lambda a: (lambda t: t.to(torch.bfloat16) if t.is_floating_point() else t)(torch.as_tensor(a)))
    B, S, D = 1024, 16, 512
    return {
        "x": _w((lambda *s: torch.randn(*s, dtype=torch.bfloat16) * 0.05)(B, S, D)),
        "g": _w((lambda *s: torch.randn(*s, dtype=torch.bfloat16) * 0.05)(D) + 1.0),
    }

def reference(x, g):
    rms = torch.sqrt((x * x).mean(axis=-1, keepdims=True) + 1e-6)
    return x / rms * g
```

```asm
; @launch grid=(256,1,1) block=(512,1,1) lds=0
.amdgcn_target "amdgcn-amd-amdhsa--gfx950"
.text
.p2align 13
.globl standalone__rmsnorm__sampling_kernel
.p2align 8
.type standalone__rmsnorm__sampling_kernel,@function
standalone__rmsnorm__sampling_kernel:
    s_load_dwordx2 s[8:9], s[0:1], 0
    s_load_dwordx4 s[4:7], s[0:1], 8
    s_getpc_b64 s[34:35]
    v_mov_b32 v1, 0
    v_lshl_add_u64 v[4:5], v[0:1], 3, s[34:35]
    global_load_dword v52, v[4:5], off offset:108
    s_cmpk_ge_u32 s2, 0x100
    s_cbranch_scc1 L_done
    s_lshl_b32 s3, s2, 13
    v_lshl_add_u32 v2, v0, 4, s3
    s_lshl_b32 s10, 1, 24
    s_lshl_b32 s11, 1, 17
    s_lshl_b32 s16, 1, 21
    s_lshl_b32 s17, 2, 21
    s_lshl_b32 s18, 3, 21
    s_waitcnt lgkmcnt(0)
    buffer_load_dwordx4 v[8:11], v2, s[8:11], 0 offen nt
    s_lshl_b32 s19, 4, 21
    s_lshl_b32 s20, 5, 21
    buffer_load_dwordx4 v[12:15], v2, s[8:11], s16 offen nt
    s_lshl_b32 s21, 6, 21
    s_lshl_b32 s22, 7, 21
    buffer_load_dwordx4 v[16:19], v2, s[8:11], s17 offen nt
    s_mov_b64 s[12:13], s[6:7]
    s_mov_b32 s14, s10
    buffer_load_dwordx4 v[20:23], v2, s[8:11], s18 offen nt
    v_bfe_u32 v1, v2, 0, 10
    global_load_dwordx4 v[40:43], v1, s[4:5]
    s_mov_b32 s15, s11
    s_mov_b32 s3, 0x3b000000
    s_mov_b32 s23, 0xffff0000
    s_mov_b32 s24, 0x3f803f80
    v_mov_b32 v3, 0x35860000
    s_waitcnt vmcnt(3)
    buffer_load_dwordx4 v[24:27], v2, s[8:11], s19 offen nt
    buffer_load_dwordx4 v[28:31], v2, s[8:11], s20 offen nt
    s_waitcnt vmcnt(3)
    buffer_load_dwordx4 v[32:35], v2, s[8:11], s21 offen nt
    buffer_load_dwordx4 v[36:39], v2, s[8:11], s22 offen nt
    v_mov_b32 v4, 0
    v_lshlrev_b32 v52, 16, v8
    v_and_b32 v53, s23, v8
    v_lshlrev_b32 v54, 16, v9
    v_and_b32 v55, s23, v9
    v_lshlrev_b32 v56, 16, v10
    v_and_b32 v57, s23, v10
    v_lshlrev_b32 v58, 16, v11
    v_and_b32 v59, s23, v11
    v_pk_mul_f32 v[84:85], v[52:53], v[52:53]
    v_pk_mul_f32 v[86:87], v[54:55], v[54:55]
    v_pk_mul_f32 v[88:89], v[56:57], v[56:57]
    v_pk_mul_f32 v[90:91], v[58:59], v[58:59]
    v_cvt_pk_bf16_f32 v84, v84, v85
    v_cvt_pk_bf16_f32 v86, v86, v87
    v_cvt_pk_bf16_f32 v88, v88, v89
    v_cvt_pk_bf16_f32 v90, v90, v91
    v_dot2c_f32_bf16 v4, s24, v84
    v_dot2c_f32_bf16 v4, s24, v86
    v_dot2c_f32_bf16 v4, s24, v88
    v_dot2c_f32_bf16 v4, s24, v90
    v_mov_b32 v5, 0
    v_lshlrev_b32 v60, 16, v12
    v_and_b32 v61, s23, v12
    v_lshlrev_b32 v62, 16, v13
    v_and_b32 v63, s23, v13
    v_lshlrev_b32 v64, 16, v14
    v_and_b32 v65, s23, v14
    v_lshlrev_b32 v66, 16, v15
    v_and_b32 v67, s23, v15
    v_pk_mul_f32 v[84:85], v[60:61], v[60:61]
    v_pk_mul_f32 v[86:87], v[62:63], v[62:63]
    v_pk_mul_f32 v[88:89], v[64:65], v[64:65]
    v_pk_mul_f32 v[90:91], v[66:67], v[66:67]
    v_cvt_pk_bf16_f32 v84, v84, v85
    v_cvt_pk_bf16_f32 v86, v86, v87
    v_cvt_pk_bf16_f32 v88, v88, v89
    v_cvt_pk_bf16_f32 v90, v90, v91
    v_dot2c_f32_bf16 v5, s24, v84
    v_dot2c_f32_bf16 v5, s24, v86
    v_dot2c_f32_bf16 v5, s24, v88
    v_dot2c_f32_bf16 v5, s24, v90
    v_mov_b32 v6, 0
    v_lshlrev_b32 v68, 16, v16
    v_and_b32 v69, s23, v16
    v_lshlrev_b32 v70, 16, v17
    v_and_b32 v71, s23, v17
    v_lshlrev_b32 v72, 16, v18
    v_and_b32 v73, s23, v18
    v_lshlrev_b32 v74, 16, v19
    v_and_b32 v75, s23, v19
    v_pk_mul_f32 v[84:85], v[68:69], v[68:69]
    v_pk_mul_f32 v[86:87], v[70:71], v[70:71]
    v_pk_mul_f32 v[88:89], v[72:73], v[72:73]
    v_pk_mul_f32 v[90:91], v[74:75], v[74:75]
    v_cvt_pk_bf16_f32 v84, v84, v85
    v_cvt_pk_bf16_f32 v86, v86, v87
    v_cvt_pk_bf16_f32 v88, v88, v89
    v_cvt_pk_bf16_f32 v90, v90, v91
    v_dot2c_f32_bf16 v6, s24, v84
    v_dot2c_f32_bf16 v6, s24, v86
    v_dot2c_f32_bf16 v6, s24, v88
    v_dot2c_f32_bf16 v6, s24, v90
    v_mov_b32 v7, 0
    v_lshlrev_b32 v76, 16, v20
    v_and_b32 v77, s23, v20
    v_lshlrev_b32 v78, 16, v21
    v_and_b32 v79, s23, v21
    v_lshlrev_b32 v80, 16, v22
    v_and_b32 v81, s23, v22
    v_lshlrev_b32 v82, 16, v23
    v_and_b32 v83, s23, v23
    v_pk_mul_f32 v[84:85], v[76:77], v[76:77]
    v_pk_mul_f32 v[86:87], v[78:79], v[78:79]
    v_pk_mul_f32 v[88:89], v[80:81], v[80:81]
    v_pk_mul_f32 v[90:91], v[82:83], v[82:83]
    v_cvt_pk_bf16_f32 v84, v84, v85
    v_cvt_pk_bf16_f32 v86, v86, v87
    v_cvt_pk_bf16_f32 v88, v88, v89
    v_cvt_pk_bf16_f32 v90, v90, v91
    v_dot2c_f32_bf16 v7, s24, v84
    v_dot2c_f32_bf16 v7, s24, v86
    v_dot2c_f32_bf16 v7, s24, v88
    v_dot2c_f32_bf16 v7, s24, v90
    s_waitcnt vmcnt(4)
    v_lshlrev_b32 v44, 16, v40
    v_and_b32 v45, s23, v40
    v_lshlrev_b32 v46, 16, v41
    v_and_b32 v47, s23, v41
    v_lshlrev_b32 v48, 16, v42
    v_and_b32 v49, s23, v42
    v_lshlrev_b32 v50, 16, v43
    v_and_b32 v51, s23, v43
    v_pk_mul_f32 v[52:53], v[52:53], v[44:45]
    v_pk_mul_f32 v[54:55], v[54:55], v[46:47]
    v_pk_mul_f32 v[56:57], v[56:57], v[48:49]
    v_permlane32_swap_b32 v4, v5
    v_permlane32_swap_b32 v6, v7
    v_add_f32 v4, v4, v5
    v_add_f32 v6, v6, v7
    v_pk_mul_f32 v[58:59], v[58:59], v[50:51]
    v_pk_mul_f32 v[60:61], v[60:61], v[44:45]
    v_permlane16_swap_b32 v4, v6
    v_add_f32 v4, v4, v6
    v_pk_mul_f32 v[62:63], v[62:63], v[46:47]
    v_pk_mul_f32 v[64:65], v[64:65], v[48:49]
    v_add_f32_dpp v4, v4, v4 row_ror:8 row_mask:0xf bank_mask:0xf
    v_pk_mul_f32 v[66:67], v[66:67], v[50:51]
    v_pk_mul_f32 v[68:69], v[68:69], v[44:45]
    v_add_f32_dpp v4, v4, v4 row_ror:4 row_mask:0xf bank_mask:0xf
    v_pk_mul_f32 v[70:71], v[70:71], v[46:47]
    v_pk_mul_f32 v[72:73], v[72:73], v[48:49]
    v_add_f32_dpp v4, v4, v4 row_ror:2 row_mask:0xf bank_mask:0xf
    v_pk_mul_f32 v[74:75], v[74:75], v[50:51]
    v_pk_mul_f32 v[76:77], v[76:77], v[44:45]
    v_add_f32_dpp v4, v4, v4 row_ror:1 row_mask:0xf bank_mask:0xf
    v_cvt_pk_bf16_f32 v4, 0, v4
    v_fma_f32 v4, v4, s3, v3
    v_cvt_pk_bf16_f32 v4, 0, v4
    v_sqrt_f32 v4, v4
    v_pk_mul_f32 v[78:79], v[78:79], v[46:47]
    v_cvt_pk_bf16_f32 v4, 0, v4
    v_rcp_f32 v4, v4
    v_pk_mul_f32 v[80:81], v[80:81], v[48:49]
    v_readlane_b32 s26, v4, 0
    v_readlane_b32 s28, v4, 32
    v_readlane_b32 s30, v4, 16
    v_readlane_b32 s32, v4, 48
    v_pk_mul_f32 v[82:83], v[82:83], v[50:51]
    v_pk_mul_f32 v[52:53], v[52:53], s[26:27] op_sel_hi:[1,0]
    v_pk_mul_f32 v[54:55], v[54:55], s[26:27] op_sel_hi:[1,0]
    v_pk_mul_f32 v[56:57], v[56:57], s[26:27] op_sel_hi:[1,0]
    v_pk_mul_f32 v[58:59], v[58:59], s[26:27] op_sel_hi:[1,0]
    v_cvt_pk_bf16_f32 v8, v52, v53
    v_cvt_pk_bf16_f32 v9, v54, v55
    v_cvt_pk_bf16_f32 v10, v56, v57
    v_cvt_pk_bf16_f32 v11, v58, v59
    v_pk_mul_f32 v[60:61], v[60:61], s[28:29] op_sel_hi:[1,0]
    v_pk_mul_f32 v[62:63], v[62:63], s[28:29] op_sel_hi:[1,0]
    v_pk_mul_f32 v[64:65], v[64:65], s[28:29] op_sel_hi:[1,0]
    v_pk_mul_f32 v[66:67], v[66:67], s[28:29] op_sel_hi:[1,0]
    v_cvt_pk_bf16_f32 v12, v60, v61
    v_cvt_pk_bf16_f32 v13, v62, v63
    v_cvt_pk_bf16_f32 v14, v64, v65
    v_cvt_pk_bf16_f32 v15, v66, v67
    v_pk_mul_f32 v[68:69], v[68:69], s[30:31] op_sel_hi:[1,0]
    v_pk_mul_f32 v[70:71], v[70:71], s[30:31] op_sel_hi:[1,0]
    v_pk_mul_f32 v[72:73], v[72:73], s[30:31] op_sel_hi:[1,0]
    v_pk_mul_f32 v[74:75], v[74:75], s[30:31] op_sel_hi:[1,0]
    v_cvt_pk_bf16_f32 v16, v68, v69
    v_cvt_pk_bf16_f32 v17, v70, v71
    v_cvt_pk_bf16_f32 v18, v72, v73
    v_cvt_pk_bf16_f32 v19, v74, v75
    v_pk_mul_f32 v[76:77], v[76:77], s[32:33] op_sel_hi:[1,0]
    v_pk_mul_f32 v[78:79], v[78:79], s[32:33] op_sel_hi:[1,0]
    v_pk_mul_f32 v[80:81], v[80:81], s[32:33] op_sel_hi:[1,0]
    v_pk_mul_f32 v[82:83], v[82:83], s[32:33] op_sel_hi:[1,0]
    v_cvt_pk_bf16_f32 v20, v76, v77
    v_cvt_pk_bf16_f32 v21, v78, v79
    v_cvt_pk_bf16_f32 v22, v80, v81
    v_cvt_pk_bf16_f32 v23, v82, v83
    v_mov_b32 v4, 0
    s_waitcnt vmcnt(3)
    v_lshlrev_b32 v52, 16, v24
    v_and_b32 v53, s23, v24
    v_lshlrev_b32 v54, 16, v25
    v_and_b32 v55, s23, v25
    v_lshlrev_b32 v56, 16, v26
    v_and_b32 v57, s23, v26
    v_lshlrev_b32 v58, 16, v27
    v_and_b32 v59, s23, v27
    v_pk_mul_f32 v[84:85], v[52:53], v[52:53]
    v_pk_mul_f32 v[86:87], v[54:55], v[54:55]
    v_pk_mul_f32 v[88:89], v[56:57], v[56:57]
    v_pk_mul_f32 v[90:91], v[58:59], v[58:59]
    v_cvt_pk_bf16_f32 v84, v84, v85
    v_cvt_pk_bf16_f32 v86, v86, v87
    v_cvt_pk_bf16_f32 v88, v88, v89
    v_cvt_pk_bf16_f32 v90, v90, v91
    v_dot2c_f32_bf16 v4, s24, v84
    v_dot2c_f32_bf16 v4, s24, v86
    v_dot2c_f32_bf16 v4, s24, v88
    v_dot2c_f32_bf16 v4, s24, v90
    v_pk_mul_f32 v[52:53], v[52:53], v[44:45]
    v_pk_mul_f32 v[54:55], v[54:55], v[46:47]
    v_pk_mul_f32 v[56:57], v[56:57], v[48:49]
    v_pk_mul_f32 v[58:59], v[58:59], v[50:51]
    v_mov_b32 v5, 0
    s_waitcnt vmcnt(2)
    v_lshlrev_b32 v60, 16, v28
    v_and_b32 v61, s23, v28
    v_lshlrev_b32 v62, 16, v29
    v_and_b32 v63, s23, v29
    v_lshlrev_b32 v64, 16, v30
    v_and_b32 v65, s23, v30
    v_lshlrev_b32 v66, 16, v31
    v_and_b32 v67, s23, v31
    v_pk_mul_f32 v[84:85], v[60:61], v[60:61]
    v_pk_mul_f32 v[86:87], v[62:63], v[62:63]
    v_pk_mul_f32 v[88:89], v[64:65], v[64:65]
    v_pk_mul_f32 v[90:91], v[66:67], v[66:67]
    v_cvt_pk_bf16_f32 v84, v84, v85
    v_cvt_pk_bf16_f32 v86, v86, v87
    v_cvt_pk_bf16_f32 v88, v88, v89
    v_cvt_pk_bf16_f32 v90, v90, v91
    v_dot2c_f32_bf16 v5, s24, v84
    v_dot2c_f32_bf16 v5, s24, v86
    v_dot2c_f32_bf16 v5, s24, v88
    v_dot2c_f32_bf16 v5, s24, v90
    v_pk_mul_f32 v[60:61], v[60:61], v[44:45]
    v_pk_mul_f32 v[62:63], v[62:63], v[46:47]
    v_pk_mul_f32 v[64:65], v[64:65], v[48:49]
    v_pk_mul_f32 v[66:67], v[66:67], v[50:51]
    v_mov_b32 v6, 0
    s_waitcnt vmcnt(1)
    v_lshlrev_b32 v68, 16, v32
    v_and_b32 v69, s23, v32
    v_lshlrev_b32 v70, 16, v33
    v_and_b32 v71, s23, v33
    v_lshlrev_b32 v72, 16, v34
    v_and_b32 v73, s23, v34
    v_lshlrev_b32 v74, 16, v35
    v_and_b32 v75, s23, v35
    v_pk_mul_f32 v[84:85], v[68:69], v[68:69]
    v_pk_mul_f32 v[86:87], v[70:71], v[70:71]
    v_pk_mul_f32 v[88:89], v[72:73], v[72:73]
    v_pk_mul_f32 v[90:91], v[74:75], v[74:75]
    v_cvt_pk_bf16_f32 v84, v84, v85
    v_cvt_pk_bf16_f32 v86, v86, v87
    v_cvt_pk_bf16_f32 v88, v88, v89
    v_cvt_pk_bf16_f32 v90, v90, v91
    v_dot2c_f32_bf16 v6, s24, v84
    v_dot2c_f32_bf16 v6, s24, v86
    v_dot2c_f32_bf16 v6, s24, v88
    v_dot2c_f32_bf16 v6, s24, v90
    v_pk_mul_f32 v[68:69], v[68:69], v[44:45]
    v_pk_mul_f32 v[70:71], v[70:71], v[46:47]
    v_pk_mul_f32 v[72:73], v[72:73], v[48:49]
    v_pk_mul_f32 v[74:75], v[74:75], v[50:51]
    s_waitcnt vmcnt(0)
    buffer_store_dwordx4 v[8:11], v2, s[12:15], 0 offen nt
    buffer_store_dwordx4 v[12:15], v2, s[12:15], s16 offen nt
    v_mov_b32 v7, 0
    v_lshlrev_b32 v76, 16, v36
    v_and_b32 v77, s23, v36
    v_lshlrev_b32 v78, 16, v37
    v_and_b32 v79, s23, v37
    v_lshlrev_b32 v80, 16, v38
    v_and_b32 v81, s23, v38
    v_lshlrev_b32 v82, 16, v39
    v_and_b32 v83, s23, v39
    v_pk_mul_f32 v[84:85], v[76:77], v[76:77]
    v_pk_mul_f32 v[86:87], v[78:79], v[78:79]
    v_pk_mul_f32 v[88:89], v[80:81], v[80:81]
    v_pk_mul_f32 v[90:91], v[82:83], v[82:83]
    v_cvt_pk_bf16_f32 v84, v84, v85
    v_cvt_pk_bf16_f32 v86, v86, v87
    v_cvt_pk_bf16_f32 v88, v88, v89
    v_cvt_pk_bf16_f32 v90, v90, v91
    v_dot2c_f32_bf16 v7, s24, v84
    v_dot2c_f32_bf16 v7, s24, v86
    v_dot2c_f32_bf16 v7, s24, v88
    v_dot2c_f32_bf16 v7, s24, v90
    buffer_store_dwordx4 v[16:19], v2, s[12:15], s17 offen nt
    buffer_store_dwordx4 v[20:23], v2, s[12:15], s18 offen nt
    v_pk_mul_f32 v[76:77], v[76:77], v[44:45]
    v_pk_mul_f32 v[78:79], v[78:79], v[46:47]
    v_pk_mul_f32 v[80:81], v[80:81], v[48:49]
    v_permlane32_swap_b32 v4, v5
    v_permlane32_swap_b32 v6, v7
    v_add_f32 v4, v4, v5
    v_add_f32 v6, v6, v7
    v_pk_mul_f32 v[82:83], v[82:83], v[50:51]
    s_nop 0
    v_permlane16_swap_b32 v4, v6
    v_add_f32 v4, v4, v6
    s_nop 1
    v_add_f32_dpp v4, v4, v4 row_ror:8 row_mask:0xf bank_mask:0xf
    s_nop 1
    v_add_f32_dpp v4, v4, v4 row_ror:4 row_mask:0xf bank_mask:0xf
    s_nop 1
    v_add_f32_dpp v4, v4, v4 row_ror:2 row_mask:0xf bank_mask:0xf
    s_nop 1
    v_add_f32_dpp v4, v4, v4 row_ror:1 row_mask:0xf bank_mask:0xf
    v_cvt_pk_bf16_f32 v4, 0, v4
    v_fma_f32 v4, v4, s3, v3
    v_cvt_pk_bf16_f32 v4, 0, v4
    v_sqrt_f32 v4, v4
    s_nop 0
    v_cvt_pk_bf16_f32 v4, 0, v4
    v_rcp_f32 v4, v4
    s_nop 0
    v_readlane_b32 s26, v4, 0
    v_readlane_b32 s28, v4, 32
    v_readlane_b32 s30, v4, 16
    v_readlane_b32 s32, v4, 48
    v_pk_mul_f32 v[52:53], v[52:53], s[26:27] op_sel_hi:[1,0]
    v_pk_mul_f32 v[54:55], v[54:55], s[26:27] op_sel_hi:[1,0]
    v_pk_mul_f32 v[56:57], v[56:57], s[26:27] op_sel_hi:[1,0]
    v_pk_mul_f32 v[58:59], v[58:59], s[26:27] op_sel_hi:[1,0]
    v_cvt_pk_bf16_f32 v24, v52, v53
    v_cvt_pk_bf16_f32 v25, v54, v55
    v_cvt_pk_bf16_f32 v26, v56, v57
    v_cvt_pk_bf16_f32 v27, v58, v59
    buffer_store_dwordx4 v[24:27], v2, s[12:15], s19 offen nt
    v_pk_mul_f32 v[60:61], v[60:61], s[28:29] op_sel_hi:[1,0]
    v_pk_mul_f32 v[62:63], v[62:63], s[28:29] op_sel_hi:[1,0]
    v_pk_mul_f32 v[64:65], v[64:65], s[28:29] op_sel_hi:[1,0]
    v_pk_mul_f32 v[66:67], v[66:67], s[28:29] op_sel_hi:[1,0]
    v_cvt_pk_bf16_f32 v28, v60, v61
    v_cvt_pk_bf16_f32 v29, v62, v63
    v_cvt_pk_bf16_f32 v30, v64, v65
    v_cvt_pk_bf16_f32 v31, v66, v67
    buffer_store_dwordx4 v[28:31], v2, s[12:15], s20 offen nt
    v_pk_mul_f32 v[68:69], v[68:69], s[30:31] op_sel_hi:[1,0]
    v_pk_mul_f32 v[70:71], v[70:71], s[30:31] op_sel_hi:[1,0]
    v_pk_mul_f32 v[72:73], v[72:73], s[30:31] op_sel_hi:[1,0]
    v_pk_mul_f32 v[74:75], v[74:75], s[30:31] op_sel_hi:[1,0]
    v_cvt_pk_bf16_f32 v32, v68, v69
    v_cvt_pk_bf16_f32 v33, v70, v71
    v_cvt_pk_bf16_f32 v34, v72, v73
    v_cvt_pk_bf16_f32 v35, v74, v75
    buffer_store_dwordx4 v[32:35], v2, s[12:15], s21 offen nt
    v_pk_mul_f32 v[76:77], v[76:77], s[32:33] op_sel_hi:[1,0]
    v_pk_mul_f32 v[78:79], v[78:79], s[32:33] op_sel_hi:[1,0]
    v_pk_mul_f32 v[80:81], v[80:81], s[32:33] op_sel_hi:[1,0]
    v_pk_mul_f32 v[82:83], v[82:83], s[32:33] op_sel_hi:[1,0]
    v_cvt_pk_bf16_f32 v36, v76, v77
    v_cvt_pk_bf16_f32 v37, v78, v79
    v_cvt_pk_bf16_f32 v38, v80, v81
    v_cvt_pk_bf16_f32 v39, v82, v83
    buffer_store_dwordx4 v[36:39], v2, s[12:15], s22 offen nt
L_done:
    s_endpgm
    .fill (standalone__rmsnorm__sampling_kernel + 4224 - . + 3) / 4, 4, 0xbf810000
.section .rodata,"a"
.p2align 6
.amdhsa_kernel standalone__rmsnorm__sampling_kernel
  .amdhsa_next_free_vgpr 92
  .amdhsa_next_free_sgpr 36
  .amdhsa_accum_offset 92
  .amdhsa_group_segment_fixed_size 0
  .amdhsa_kernarg_size 40
  .amdhsa_user_sgpr_count 2
  .amdhsa_user_sgpr_kernarg_segment_ptr 1
  .amdhsa_system_sgpr_workgroup_id_x 1
  .amdhsa_float_denorm_mode_32 3
.end_amdhsa_kernel
```
